```python
import torch

def _softmax(x, axis=-1):
    return torch.softmax(x, dim=axis)
def _gelu(x):
    return torch.nn.functional.gelu(x, approximate="tanh")
def _silu(x):
    return torch.nn.functional.silu(x)
def _sigmoid(x):
    return torch.sigmoid(x)
def _layernorm(x, axis=-1, eps=1e-5):
    m = x.mean(dim=axis, keepdim=True)
    v = x.var(dim=axis, keepdim=True, unbiased=False)
    return (x - m) / torch.sqrt(v + eps)
def _scatter_add(tgt, idx, src, axis=0):
    return tgt.clone().index_add_(axis, idx, src)
def _segment_sum(src, seg, n):
    out = torch.zeros((n,) + src.shape[1:], dtype=src.dtype)
    return out.index_add_(0, seg, src)
def _pad(x, pw):
    flat = tuple(v for pair in reversed(pw) for v in pair)
    return torch.nn.functional.pad(x, flat)

kernel_name = 'standalone__instancenorm__sampling'

def setup_inputs():

    _w = (lambda a: (lambda t: t.to(torch.bfloat16) if t.is_floating_point() else t)(torch.as_tensor(a)))
    B, C, H, W = 64, 1024, 4, 32
    return {
        "x": _w(abs((lambda *s: torch.randn(*s, dtype=torch.bfloat16) * 0.05)(B, C, H, W))),
        "g": _w((lambda *s: torch.randn(*s, dtype=torch.bfloat16) * 0.05)(C) + 1.0),
        "b": _w((lambda *s: torch.randn(*s, dtype=torch.bfloat16) * 0.4)(C)),
    }

def reference(x, g, b):
    mu = x.mean(axis=(-2, -1), keepdims=True)
    var = ((x - mu) ** 2).mean(axis=(-2, -1), keepdims=True)
    xhat = (x - mu) / torch.sqrt(var + 1e-5)
    return xhat * g.reshape(1, -1, 1, 1) + b.reshape(1, -1, 1, 1)
```

```asm
; @launch grid=(256,1,1) block=(1024,1,1) lds=0
.amdgcn_target "amdgcn-amd-amdhsa--gfx950"
.text
.globl standalone__instancenorm__sampling_kernel
.p2align 12
.p2align 8
.type standalone__instancenorm__sampling_kernel,@function
standalone__instancenorm__sampling_kernel:
    s_load_dwordx8 s[4:11], s[0:1], 0
    s_load_dwordx2 s[30:31], s[0:1], 32
    s_cmpk_ge_u32 s2, 256
    s_cbranch_scc1 L_end
    v_readfirstlane_b32 s32, v0
    v_and_b32 v1, 63, v0
    v_lshlrev_b32 v1, 4, v1
    v_and_b32 v2, 48, v0
    s_lshl_b32 s26, s32, 4
    s_and_b32 s3, s2, 3
    s_lshl_b32 s3, s3, 14
    s_or_b32 s26, s26, s3
    s_lshr_b32 s3, s2, 3
    s_lshl_b32 s3, s3, 16
    s_or_b32 s26, s26, s3
    s_bfe_u32 s38, s26, 0xb0007
    s_lshr_b32 s3, s26, 13
    s_lshl2_add_u32 s28, s3, s2
    s_lshr_b32 s3, s32, 4
    s_xor_b32 s3, s3, s28
    s_and_b32 s3, s3, 4
    s_lshl_b32 s3, s3, 19
    s_or_b32 s24, s26, s3
    v_or_b32 v3, s24, v1
    s_or_b32 s3, s32, s2
    s_cmp_lt_u32 s3, 16
    s_cbranch_scc1 L_probe
    s_waitcnt lgkmcnt(0)
L_go:
    global_load_dwordx4 v[10:13], v3, s[4:5] nt
    s_mov_b64 s[12:13], s[4:5]
    s_or_b32 s23, s24, 0x400000
    s_bitset1_b32 s26, 23
    v_mov_b32 v5, 0x3827c5ac
    s_mov_b32 s14, 0x1000000
    s_mov_b32 s15, 0x20000
    s_mov_b64 s[18:19], s[14:15]
    s_mov_b32 s20, 0xbc00bc00
    s_mov_b32 s21, 0x3f80
    s_mov_b32 s22, 1.0
    s_movk_i32 s33, 32
    s_load_dwordx2 s[40:41], s[6:7], s38
    s_load_dwordx2 s[44:45], s[8:9], s38
    s_mul_i32 s39, s32, 0x88
    s_and_b32 s39, s39, 0x2e00
    s_lshr_b32 s3, s32, 7
    s_lshl_b32 s3, s3, 17
    s_or_b32 s39, s39, s3
    s_lshr_b32 s3, s2, 3
    s_lshl_b32 s3, s3, 8
    s_xor_b32 s39, s39, s3
    s_and_b32 s3, s2, 3
    s_mul_i32 s3, s3, 0x84000
    s_and_b32 s3, s3, 0x104000
    s_xor_b32 s39, s39, s3
    v_lshl_add_u32 v0, v2, 11, v1
    v_xor_b32 v0, s39, v0
    v_lshrrev_b32 v28, 7, v0
    v_and_b32 v28, 0x7fe, v28
    s_waitcnt vmcnt(0)
    buffer_load_dwordx4 v[22:25], v1, s[12:15], s23 offen nt
    s_mov_b64 s[16:17], s[10:11]
    s_waitcnt lgkmcnt(0)
    v_lshrrev_b64 v[8:9], v2, s[40:41]
    v_lshrrev_b64 v[6:7], v2, s[44:45]
    v_lshlrev_b32 v4, 16, v8
    v_lshlrev_b32 v7, 16, v6
    v_mul_f32 v4, 0x413504f3, v4
    s_branch L_body
L_s1:
    s_waitcnt vmcnt(1)
    s_load_dword s29, s[30:31], 0
    v_mov_b64 v[10:11], v[22:23]
    v_mov_b64 v[12:13], v[24:25]
    s_waitcnt lgkmcnt(0)
L_chk:
    s_add_u32 s3, s29, s28
    s_and_b32 s3, s3, 4
    s_lshl_b32 s3, s3, 19
    s_or_b32 s23, s26, s3
    s_cmp_eq_u32 s29, 0
    s_cbranch_scc1 L_slow
    buffer_load_dwordx4 v[22:25], v1, s[12:15], s23 offen nt
    s_branch L_body
L_s2:
    s_lshr_b32 s3, s39, 11
    s_add_u32 s23, s29, s2
    s_xor_b32 s3, s3, s23
    s_and_b32 s3, s3, 4
    s_or_b32 s3, s3, 24
    s_lshl_b32 s23, s3, 19
    s_waitcnt vmcnt(1)
    v_mov_b64 v[10:11], v[22:23]
    v_mov_b64 v[12:13], v[24:25]
    s_branch L_body
L_s3:
    global_load_ushort v26, v28, s[6:7]
    global_load_ushort v27, v28, s[8:9]
    buffer_load_dwordx4 v[10:13], v0, s[12:15], s24 offen nt
    v_mov_b32 v1, v0
    s_waitcnt vmcnt(1)
    v_lshlrev_b32 v4, 16, v26
    v_lshlrev_b32 v7, 16, v27
    v_mul_f32 v4, 0x413504f3, v4
    s_waitcnt vmcnt(0)
L_body:
    v_dot2_f32_bf16 v3, v10, s20, 0
    v_dot2_f32_bf16 v3, v11, s20, v3
    v_dot2_f32_bf16 v3, v12, s20, v3
    v_dot2_f32_bf16 v3, v13, s20, v3
    s_lshr_b32 s27, s24, 22
    s_mov_b32 s25, s24
    s_mov_b32 s24, s23
    v_add_f32_dpp v3, v3, v3 row_ror:8 row_mask:0xf bank_mask:0xf
    s_nop 1
    v_add_f32_dpp v3, v3, v3 row_ror:4 row_mask:0xf bank_mask:0xf
    s_nop 1
    v_add_f32_dpp v3, v3, v3 row_ror:2 row_mask:0xf bank_mask:0xf
    s_nop 1
    v_add_f32_dpp v3, v3, v3 row_ror:1 row_mask:0xf bank_mask:0xf
    v_cvt_pk_bf16_f32 v3, 0, v3
    v_dot2_f32_bf16 v14, v10, s21, v3
    v_dot2_f32_bf16 v15, v10, s22, v3
    v_dot2_f32_bf16 v16, v11, s21, v3
    v_dot2_f32_bf16 v17, v11, s22, v3
    v_dot2_f32_bf16 v18, v12, s21, v3
    v_dot2_f32_bf16 v19, v12, s22, v3
    v_dot2_f32_bf16 v20, v13, s21, v3
    v_dot2_f32_bf16 v21, v13, s22, v3
    v_pk_fma_f32 v[8:9], v[14:15], v[14:15], v[4:5] op_sel:[0,0,1] op_sel_hi:[1,1,1]
    v_pk_fma_f32 v[8:9], v[16:17], v[16:17], v[8:9]
    v_pk_fma_f32 v[8:9], v[18:19], v[18:19], v[8:9]
    v_pk_fma_f32 v[8:9], v[20:21], v[20:21], v[8:9]
    v_add_f32 v8, v8, v9
    s_nop 1
    v_add_f32_dpp v8, v8, v8 row_ror:8 row_mask:0xf bank_mask:0xf
    s_nop 1
    v_add_f32_dpp v8, v8, v8 row_ror:4 row_mask:0xf bank_mask:0xf
    s_nop 1
    v_add_f32_dpp v8, v8, v8 row_ror:2 row_mask:0xf bank_mask:0xf
    s_nop 1
    v_add_f32_dpp v8, v8, v8 row_ror:1 row_mask:0xf bank_mask:0xf
    v_rsq_f32 v8, v8
    s_cmp_eq_u32 s27, 2
    v_mul_f32 v6, v8, v4
    v_pk_fma_f32 v[14:15], v[14:15], v[6:7], v[6:7] op_sel:[0,0,1] op_sel_hi:[1,0,1]
    v_pk_fma_f32 v[16:17], v[16:17], v[6:7], v[6:7] op_sel:[0,0,1] op_sel_hi:[1,0,1]
    v_pk_fma_f32 v[18:19], v[18:19], v[6:7], v[6:7] op_sel:[0,0,1] op_sel_hi:[1,0,1]
    v_pk_fma_f32 v[20:21], v[20:21], v[6:7], v[6:7] op_sel:[0,0,1] op_sel_hi:[1,0,1]
    v_cvt_pk_bf16_f32 v14, v14, v15
    v_cvt_pk_bf16_f32 v15, v16, v17
    v_cvt_pk_bf16_f32 v16, v18, v19
    v_cvt_pk_bf16_f32 v17, v20, v21
    buffer_store_dwordx4 v[14:17], v1, s[16:19], s25 offen sc1
    s_cbranch_scc1 L_s3
    s_cmp_eq_u32 s27, 0
    s_cbranch_scc1 L_s1
    s_cmp_eq_u32 s27, 1
    s_cbranch_scc1 L_s2
L_end:
    s_endpgm

L_probe:
    s_bfe_u32 s27, s2, 0x10003
    s_lshl_b32 s34, s27, 13
    s_lshl_b32 s3, s2, 8
    s_add_u32 s34, s34, s3
    s_or_b32 s34, s34, 0xc00000
    s_xor_b32 s35, s34, 0x2000
    v_mov_b32 v9, 0
    s_waitcnt lgkmcnt(0)
    s_load_dword s34, s[4:5], s34
    s_load_dwordx2 s[36:37], s[4:5], s35
    s_waitcnt lgkmcnt(2)
    s_mov_b64 exec, 1
    s_getreg_b32 s3, hwreg(HW_REG_XCC_ID, 0, 2)
    s_lshl2_add_u32 s27, s27, s3
    s_sub_u32 s27, s27, s2
    s_getreg_b32 s3, hwreg(HW_REG_IB_STS, 9, 1)
    s_lshl2_add_u32 s27, s3, s27
    s_and_b32 s27, s27, 7
    s_xor_b32 s27, s27, 12
    v_mov_b32 v8, s27
    global_atomic_cmpswap v9, v[8:9], s[30:31] sc1
    s_mov_b64 exec, -1
    s_branch L_go

L_slow:
    v_mov_b32 v9, 0
    s_sub_u32 s33, s33, 1
    s_cbranch_scc1 L_force
    s_waitcnt vmcnt(0)
    global_load_dword v8, v9, s[30:31] sc1
    s_waitcnt vmcnt(0)
    v_readfirstlane_b32 s29, v8
    s_branch L_chk
L_force:
    v_mov_b32 v8, 8
    s_mov_b64 exec, 1
    global_atomic_cmpswap v8, v9, v[8:9], s[30:31] sc0 sc1
    s_waitcnt vmcnt(0)
    v_readfirstlane_b32 s29, v8
    s_mov_b64 exec, -1
    s_max_u32 s29, s29, 8
    s_branch L_chk
    s_endpgm
.section .rodata,"a"
.p2align 6
.amdhsa_kernel standalone__instancenorm__sampling_kernel
  .amdhsa_next_free_vgpr 29
  .amdhsa_next_free_sgpr 46
  .amdhsa_accum_offset 32
  .amdhsa_group_segment_fixed_size 0
  .amdhsa_kernarg_size 48
  .amdhsa_user_sgpr_count 2
  .amdhsa_user_sgpr_kernarg_segment_ptr 1
  .amdhsa_system_sgpr_workgroup_id_x 1
  .amdhsa_float_denorm_mode_32 3
.end_amdhsa_kernel
```
